```python
import torch

def _softmax(x, axis=-1):
    return torch.softmax(x, dim=axis)
def _gelu(x):
    return torch.nn.functional.gelu(x, approximate="tanh")
def _silu(x):
    return torch.nn.functional.silu(x)
def _sigmoid(x):
    return torch.sigmoid(x)
def _layernorm(x, axis=-1, eps=1e-5):
    m = x.mean(dim=axis, keepdim=True)
    v = x.var(dim=axis, keepdim=True, unbiased=False)
    return (x - m) / torch.sqrt(v + eps)
def _scatter_add(tgt, idx, src, axis=0):
    return tgt.clone().index_add_(axis, idx, src)
def _segment_sum(src, seg, n):
    out = torch.zeros((n,) + src.shape[1:], dtype=src.dtype)
    return out.index_add_(0, seg, src)
def _pad(x, pw):
    flat = tuple(v for pair in reversed(pw) for v in pair)
    return torch.nn.functional.pad(x, flat)

kernel_name = 'concat_heads__sliding_block_cached__sliding_block_cached__decode'

def setup_inputs():

    _w = (lambda a: (lambda t: t.to(torch.bfloat16) if t.is_floating_point() else t)(torch.as_tensor(a)))
    def _A_setup():
        B, Sq, D = 2, 1, 1024
        Hq, Hkv, Sk, Dh = 32, 4, 32768, 128
        assert Hq % Hkv == 0, (Hq, Hkv)
        return {
            "x": _w((lambda *s: torch.randn(*s, dtype=torch.bfloat16) * 0.8)(B, Sq, D)),
            "k_cache": _w((lambda *s: torch.randn(*s, dtype=torch.bfloat16) * 0.8)(B, Hkv, Sk, Dh)),
            "v_cache": _w((lambda *s: torch.randn(*s, dtype=torch.bfloat16) * 0.05)(B, Hkv, Sk, Dh)),
            "wq": _w((lambda *s: torch.randn(*s, dtype=torch.bfloat16) * 0.8)(D, Hq * Dh) * (D ** -0.5)),
            "wo": _w((lambda *s: torch.randn(*s, dtype=torch.bfloat16) * 0.05)(Hq * Dh, D) * ((Hq * Dh) ** -0.5)),
        }
    _A_in = _A_setup()

    def _B_setup():
        B, Sq, D = 2, 1, 1024
        Hq, Hkv, Sk, Dh = 32, 4, 32768, 128
        assert Hq % Hkv == 0, (Hq, Hkv)
        return {
            "x": _w((lambda *s: torch.randn(*s, dtype=torch.bfloat16) * 0.8)(B, Sq, D)),
            "k_cache": _w((lambda *s: torch.randn(*s, dtype=torch.bfloat16) * 0.8)(B, Hkv, Sk, Dh)),
            "v_cache": _w((lambda *s: torch.randn(*s, dtype=torch.bfloat16) * 0.05)(B, Hkv, Sk, Dh)),
            "wq": _w((lambda *s: torch.randn(*s, dtype=torch.bfloat16) * 0.8)(D, Hq * Dh) * (D ** -0.5)),
            "wo": _w((lambda *s: torch.randn(*s, dtype=torch.bfloat16) * 0.05)(Hq * Dh, D) * ((Hq * Dh) ** -0.5)),
        }
    _B_in = _B_setup()

    return {
        "A_x": _A_in["x"],
        "A_k_cache": _A_in["k_cache"],
        "A_v_cache": _A_in["v_cache"],
        "A_wq": _A_in["wq"],
        "A_wo": _A_in["wo"],
        "B_x": _B_in["x"],
        "B_k_cache": _B_in["k_cache"],
        "B_v_cache": _B_in["v_cache"],
        "B_wq": _B_in["wq"],
        "B_wo": _B_in["wo"],
    }

def reference(A_x, A_k_cache, A_v_cache, A_wq, A_wo, B_x, B_k_cache, B_v_cache, B_wq, B_wo):
    def _A_ref(x, k_cache, v_cache, wq, wo):
        B, Sq, D = x.shape
        Hq, Dh = 32, 128
        Hkv, Sk = k_cache.shape[1], k_cache.shape[2]
        W = min(4096, max(256, Sk // 4))
        rep = Hq // Hkv
        q = (lambda x, *d: x.permute(*d))((x @ wq).reshape(B, Sq, Hq, Dh), 0, 2, 1, 3)
        k = (lambda x, n, axis: torch.repeat_interleave(x, n, dim=axis))(k_cache[:, :, Sk - W:, :], rep, axis=1)
        v = (lambda x, n, axis: torch.repeat_interleave(x, n, dim=axis))(v_cache[:, :, Sk - W:, :], rep, axis=1)
        scores = torch.einsum("bhqd,bhkd->bhqk", q, k) * (Dh ** -0.5)
        p = _softmax(scores, axis=-1)
        o = torch.einsum("bhqk,bhkd->bhqd", p, v)
        return (lambda x, *d: x.permute(*d))(o, 0, 2, 1, 3).reshape(B, Sq, Hq * Dh) @ wo

    def _B_ref(x, k_cache, v_cache, wq, wo):
        B, Sq, D = x.shape
        Hq, Dh = 32, 128
        Hkv, Sk = k_cache.shape[1], k_cache.shape[2]
        W = min(4096, max(256, Sk // 4))
        rep = Hq // Hkv
        q = (lambda x, *d: x.permute(*d))((x @ wq).reshape(B, Sq, Hq, Dh), 0, 2, 1, 3)
        k = (lambda x, n, axis: torch.repeat_interleave(x, n, dim=axis))(k_cache[:, :, Sk - W:, :], rep, axis=1)
        v = (lambda x, n, axis: torch.repeat_interleave(x, n, dim=axis))(v_cache[:, :, Sk - W:, :], rep, axis=1)
        scores = torch.einsum("bhqd,bhkd->bhqk", q, k) * (Dh ** -0.5)
        p = _softmax(scores, axis=-1)
        o = torch.einsum("bhqk,bhkd->bhqd", p, v)
        return (lambda x, *d: x.permute(*d))(o, 0, 2, 1, 3).reshape(B, Sq, Hq * Dh) @ wo

    a = _A_ref(A_x, A_k_cache, A_v_cache, A_wq, A_wo)
    b = _B_ref(B_x, B_k_cache, B_v_cache, B_wq, B_wo)
    return torch.concatenate([a, b], axis=-1)
```

```asm
; @launch grid=(256,1,1) block=(512,1,1) lds=29184
.amdgcn_target "amdgcn-amd-amdhsa--gfx950"
.text
.globl concat_heads__sliding_block_cached__sliding_block_cached__decode_kernel
.p2align 8
.type concat_heads__sliding_block_cached__sliding_block_cached__decode_kernel,@function
concat_heads__sliding_block_cached__sliding_block_cached__decode_kernel:
    s_and_b32 s4, s2, 4
    s_mul_i32 s5, s4, 10
    s_load_dwordx2 s[40:41], s[0:1], s5 offset:24
    s_load_dwordx2 s[48:49], s[0:1], 96
    s_cmpk_ge_u32 s2, 0x100
    s_cbranch_scc1 L_end
    v_cmp_gt_u32 vcc, 0x100, v0
    v_mov_b32 v9, 0
    s_lshl_b32 s43, 1, 17
    ds_write_b8 v0, v9
    s_cbranch_vccnz L_nopf
    s_getpc_b64 s[62:63]
    v_and_b32 v1, 0xff, v0
    v_mul_u32_u24 v1, 40, v1
    global_load_dword v60, v1, s[62:63]
L_nopf:
    s_lshl_b32 s42, 1, 23
    s_andn2_b32 s58, s2, 4
    s_mul_i32 s58, s58, 0x20808
    s_and_b32 s58, s58, 0x301f00
    v_mul_u32_u24 v1, 0x1010, v0
    v_and_b32 v1, 0xf00f0, v1
    s_waitcnt lgkmcnt(0)
    s_cbranch_vccz L_bar
    buffer_load_dwordx4 v[64:67], v1, s[40:43], s58 offen nt
    s_addk_i32 s58, 0x2000
    buffer_load_dwordx4 v[68:71], v1, s[40:43], s58 offen nt
    s_addk_i32 s58, 0x2000
    buffer_load_dwordx4 v[72:75], v1, s[40:43], s58 offen nt
    s_addk_i32 s58, 0x2000
    buffer_load_dwordx4 v[76:79], v1, s[40:43], s58 offen nt
    s_addk_i32 s58, 0x2000
    buffer_load_dwordx4 v[80:83], v1, s[40:43], s58 offen nt
    s_addk_i32 s58, 0x2000
    buffer_load_dwordx4 v[84:87], v1, s[40:43], s58 offen nt
L_bar:
    s_lshl_b32 s14, s4, 5
    s_barrier
    s_cbranch_vccz L_helper
    s_load_dwordx2 s[12:13], s[0:1], s5 offset:0
    s_load_dwordx2 s[32:33], s[0:1], s5 offset:8
    s_load_dwordx2 s[36:37], s[0:1], s5 offset:16
    s_load_dwordx2 s[44:45], s[0:1], s5 offset:32
    s_lshr_b32 s7, s2, 3
    v_and_b32 v12, 15, v0
    v_lshrrev_b32 v13, 4, v0
    s_and_b32 s10, s7, 3
    s_lshl_b32 s10, s10, 8
    v_lshrrev_b32 v14, 3, v12
    v_lshlrev_b32 v14, 11, v14
    v_lshl_or_b32 v14, v13, 4, v14
    v_or_b32 v14, s10, v14
    s_mov_b32 s52, 0x05040100
    s_mov_b32 s53, 0x07060302
    s_waitcnt lgkmcnt(0)
    global_load_dwordx4 v[16:19], v14, s[12:13]
    global_load_dwordx4 v[20:23], v14, s[12:13] offset:1024
    s_load_dwordx2 s[8:9], s[48:49], s14 offset:0x40000
    s_load_dwordx2 s[26:27], s[12:13], 0
    s_waitcnt vmcnt(7)
    s_addk_i32 s58, 0x2000
    buffer_load_dwordx4 v[88:91], v1, s[40:43], s58 offen nt
    v_lshrrev_b32 v11, 6, v0
    v_mov_b32 v10, 1
    v_readfirstlane_b32 s3, v11
    s_and_b32 s6, s2, 3
    s_lshl_b32 s50, 1, 21
    s_mov_b32 s51, s43
    s_lshl_b32 s34, 1, 26
    s_mov_b32 s35, s43
    s_mov_b32 s38, s34
    s_mov_b32 s39, s43
    s_mov_b32 s46, s42
    s_mov_b32 s47, s43
    s_mov_b32 s54, 0xffff0000
    s_mov_b32 s55, s54
    s_mov_b32 s56, 0xff00ff00
    s_mov_b32 s57, s56
    s_and_b32 s10, s7, 15
    s_lshr_b32 s11, s7, 4
    s_waitcnt vmcnt(7)
    s_addk_i32 s58, 0x2000
    buffer_load_dwordx4 v[92:95], v1, s[40:43], s58 offen nt
    v_perm_b32 v32, v68, v64, s52
    v_perm_b32 v36, v68, v64, s53
    v_perm_b32 v40, v69, v65, s52
    v_perm_b32 v44, v69, v65, s53
    v_perm_b32 v48, v70, v66, s52
    v_perm_b32 v52, v70, v66, s53
    v_perm_b32 v56, v71, v67, s52
    v_perm_b32 v60, v71, v67, s53
    s_waitcnt vmcnt(7)
    s_add_u32 s58, s58, 0x3f2000
    buffer_load_dwordx4 v[96:99], v1, s[40:43], s58 offen nt
    s_lshl_b32 s10, s10, 14
    s_lshl_b32 s14, s6, 23
    s_lshl_b32 s15, s11, 25
    s_lshl_b32 s11, s11, 19
    s_or_b32 s10, s10, s14
    s_or_b32 s10, s10, s15
    s_or_b32 s10, s10, 0x700000
    s_or_b32 s28, s10, s11
    s_xor_b32 s29, s28, 0x40000
    s_xor_b32 s30, s28, 0x80000
    s_xor_b32 s31, s28, 0xc0000
    v_and_b32 v15, 3, v13
    v_lshlrev_b32 v2, 4, v15
    v_lshl_or_b32 v2, v11, 12, v2
    v_bfe_u32 v14, v0, 1, 1
    v_lshl_or_b32 v2, v14, 6, v2
    v_bfe_u32 v14, v0, 2, 2
    v_lshl_or_b32 v2, v14, 8, v2
    s_waitcnt vmcnt(7)
    s_addk_i32 s58, 0x2000
    buffer_load_dwordx4 v[100:103], v1, s[40:43], s58 offen nt
    v_perm_b32 v33, v76, v72, s52
    v_perm_b32 v37, v76, v72, s53
    v_perm_b32 v41, v77, v73, s52
    v_perm_b32 v45, v77, v73, s53
    v_perm_b32 v49, v78, v74, s52
    v_perm_b32 v53, v78, v74, s53
    v_perm_b32 v57, v79, v75, s52
    v_perm_b32 v61, v79, v75, s53
    s_waitcnt vmcnt(7)
    s_addk_i32 s58, 0x2000
    buffer_load_dwordx4 v[104:107], v1, s[40:43], s58 offen nt
    v_and_b32 v14, 1, v0
    v_lshl_or_b32 v2, v14, 10, v2
    v_lshlrev_b32 v8, 6, v14
    v_lshl_add_u32 v8, v15, 4, v8
    v_and_b32 v14, 63, v0
    v_lshlrev_b32 v3, 4, v14
    v_lshl_or_b32 v3, v11, 12, v3
    s_lshl_b32 s10, s7, 18
    s_lshl_b32 s11, s6, 9
    s_or_b32 s10, s10, s11
    s_lshl_b32 s11, s3, 7
    s_or_b32 s10, s10, s11
    v_and_b32 v14, 7, v12
    v_lshlrev_b32 v4, 14, v15
    v_lshl_or_b32 v4, v14, 4, v4
    v_or_b32 v4, s10, v4
    v_mul_u32_u24 v7, 272, v14
    v_lshl_add_u32 v7, v15, 4, v7
    s_waitcnt vmcnt(7)
    s_addk_i32 s58, 0x2000
    buffer_load_dwordx4 v[108:111], v1, s[40:43], s58 offen nt
    v_perm_b32 v34, v84, v80, s52
    v_perm_b32 v38, v84, v80, s53
    v_perm_b32 v42, v85, v81, s52
    v_perm_b32 v46, v85, v81, s53
    v_perm_b32 v50, v86, v82, s52
    v_perm_b32 v54, v86, v82, s53
    v_perm_b32 v58, v87, v83, s52
    v_perm_b32 v62, v87, v83, s53
    s_waitcnt vmcnt(5)
    s_addk_i32 s58, 0x2000
    buffer_load_dwordx4 v[112:115], v1, s[40:43], s58 offen nt
    v_lshrrev_b32 v14, 3, v12
    v_lshl_or_b32 v4, v14, 16, v4
    v_lshl_add_u32 v7, v14, 6, v7
    v_mul_u32_u24 v14, 384, v14
    v_add_u32 v8, v8, v14
    v_lshrrev_b32 v14, 1, v15
    v_lshlrev_b32 v5, 9, v14
    v_lshl_or_b32 v5, v12, 5, v5
    v_lshlrev_b32 v30, 2, v14
    v_and_b32 v14, 1, v15
    v_lshl_or_b32 v5, v14, 4, v5
    v_lshl_add_u32 v6, v11, 10, v5
    v_mul_u32_u24 v28, 272, v15
    v_lshl_add_u32 v28, v12, 4, v28
    s_mul_i32 s11, s3, 5248
    v_add_u32 v28, s11, v28
    v_lshlrev_b32 v29, 5, v12
    v_lshl_add_u32 v29, v11, 3, v29
    s_waitcnt vmcnt(5)
    s_addk_i32 s58, 0x2000
    buffer_load_dwordx4 v[116:119], v1, s[40:43], s58 offen nt
    v_perm_b32 v35, v92, v88, s52
    v_perm_b32 v39, v92, v88, s53
    v_perm_b32 v43, v93, v89, s52
    v_perm_b32 v47, v93, v89, s53
    v_perm_b32 v51, v94, v90, s52
    v_perm_b32 v55, v94, v90, s53
    v_perm_b32 v59, v95, v91, s52
    v_perm_b32 v63, v95, v91, s53
    s_nop 1
    v_mfma_f32_16x16x32_bf16 v[192:195], v[16:19], v[32:35], 0
    v_mfma_f32_16x16x32_bf16 v[208:211], v[16:19], v[48:51], 0
    v_mfma_f32_16x16x32_bf16 v[196:199], v[16:19], v[36:39], 0
    v_mfma_f32_16x16x32_bf16 v[212:215], v[16:19], v[52:55], 0
    v_mfma_f32_16x16x32_bf16 v[200:203], v[16:19], v[40:43], 0
    v_mfma_f32_16x16x32_bf16 v[216:219], v[16:19], v[56:59], 0
    v_mfma_f32_16x16x32_bf16 v[204:207], v[16:19], v[44:47], 0
    v_mfma_f32_16x16x32_bf16 v[220:223], v[16:19], v[60:63], 0
    s_waitcnt vmcnt(5)
    s_addk_i32 s58, 0x2000
    buffer_load_dwordx4 v[120:123], v1, s[40:43], s58 offen nt
    v_bfe_u32 v14, v0, 1, 2
    v_add_u32 v30, v30, v14
    v_mul_u32_u24 v30, 2176, v30
    v_and_b32 v14, 63, v5
    v_add_u32 v30, v30, v14
    s_and_b32 s10, s2, 7
    s_mul_i32 s10, s10, 69632
    s_mul_i32 s11, s3, 17408
    s_add_u32 s10, s10, s11
    s_lshl_b32 s11, s7, 6
    s_add_u32 s10, s10, s11
    s_add_u32 s59, s10, 0x50000
    s_mov_b32 s60, 0x3e0293ee
    s_not_b64 s[24:25], s[56:57]
    v_mov_b32 v31, 0xfff
    s_waitcnt vmcnt(5)
    s_addk_i32 s58, 0x2000
    buffer_load_dwordx4 v[124:127], v1, s[40:43], s58 offen nt
    v_perm_b32 v32, v100, v96, s52
    v_perm_b32 v36, v100, v96, s53
    v_perm_b32 v40, v101, v97, s52
    v_perm_b32 v44, v101, v97, s53
    v_perm_b32 v48, v102, v98, s52
    v_perm_b32 v52, v102, v98, s53
    v_perm_b32 v56, v103, v99, s52
    v_perm_b32 v60, v103, v99, s53
    s_waitcnt vmcnt(5)
    buffer_load_dwordx4 v[128:131], v2, s[32:35], s28 offen offset:0 nt
    s_waitcnt lgkmcnt(0)
    s_xor_b64 s[26:27], s[26:27], s[8:9]
    s_mul_i32 s16, s26, 0x9e3779b1
    s_xor_b32 s16, s16, s27
    s_mul_hi_u32 s17, s16, 0x85ebca6b
    s_mul_i32 s16, s16, 0x85ebca6b
    s_xor_b32 s16, s16, s17
    s_mul_hi_u32 s17, s16, 0xc2b2ae35
    s_or_b32 s16, s16, 0x11311911
    s_or_b32 s17, s17, 0x200801
    s_xor_b32 s8, s8, s16
    s_xor_b32 s9, s9, s17
    s_and_b32 s20, s8, 0x7ff
    s_bfe_u32 s21, s8, 0xb000b
    s_and_b32 s22, s9, 0x7ff
    s_bfe_u32 s23, s9, 0xb000b
    s_bitset1_b32 s20, 11
    s_bitset1_b32 s21, 11
    s_bitset1_b32 s22, 11
    s_bitset1_b32 s23, 11
    s_waitcnt vmcnt(5)
    buffer_load_dwordx4 v[132:135], v2, s[32:35], s28 offen offset:128 nt
    v_perm_b32 v33, v108, v104, s52
    v_perm_b32 v37, v108, v104, s53
    v_perm_b32 v41, v109, v105, s52
    v_perm_b32 v45, v109, v105, s53
    v_perm_b32 v49, v110, v106, s52
    v_perm_b32 v53, v110, v106, s53
    v_perm_b32 v57, v111, v107, s52
    v_perm_b32 v61, v111, v107, s53
    s_waitcnt vmcnt(5)
    buffer_load_dwordx4 v[136:139], v2, s[32:35], s28 offen offset:2048 nt
    s_waitcnt vmcnt(5)
    buffer_load_dwordx4 v[140:143], v2, s[32:35], s28 offen offset:2176 nt
    v_perm_b32 v34, v116, v112, s52
    v_perm_b32 v38, v116, v112, s53
    v_perm_b32 v42, v117, v113, s52
    v_perm_b32 v46, v117, v113, s53
    v_perm_b32 v50, v118, v114, s52
    v_perm_b32 v54, v118, v114, s53
    v_perm_b32 v58, v119, v115, s52
    v_perm_b32 v62, v119, v115, s53
    s_waitcnt vmcnt(5)
    buffer_load_dwordx4 v[144:147], v2, s[32:35], s29 offen offset:0 nt
    s_waitcnt vmcnt(5)
    buffer_load_dwordx4 v[148:151], v2, s[32:35], s29 offen offset:128 nt
    v_perm_b32 v35, v124, v120, s52
    v_perm_b32 v39, v124, v120, s53
    v_perm_b32 v43, v125, v121, s52
    v_perm_b32 v47, v125, v121, s53
    v_perm_b32 v51, v126, v122, s52
    v_perm_b32 v55, v126, v122, s53
    v_perm_b32 v59, v127, v123, s52
    v_perm_b32 v63, v127, v123, s53
    s_nop 1
    v_mfma_f32_16x16x32_bf16 v[192:195], v[20:23], v[32:35], v[192:195]
    v_mfma_f32_16x16x32_bf16 v[208:211], v[20:23], v[48:51], v[208:211]
    v_mfma_f32_16x16x32_bf16 v[196:199], v[20:23], v[36:39], v[196:199]
    v_mfma_f32_16x16x32_bf16 v[212:215], v[20:23], v[52:55], v[212:215]
    v_mfma_f32_16x16x32_bf16 v[200:203], v[20:23], v[40:43], v[200:203]
    v_mfma_f32_16x16x32_bf16 v[216:219], v[20:23], v[56:59], v[216:219]
    v_mfma_f32_16x16x32_bf16 v[204:207], v[20:23], v[44:47], v[204:207]
    v_mfma_f32_16x16x32_bf16 v[220:223], v[20:23], v[60:63], v[220:223]
    s_nop 4
    v_cndmask_b32 v24, v192, v208, s[54:55]
    v_cndmask_b32 v25, v196, v212, s[54:55]
    v_cndmask_b32 v26, v200, v216, s[54:55]
    v_cndmask_b32 v27, v204, v220, s[54:55]
    ds_write_b128 v6, v[24:27] offset:4096
    s_mov_b64 exec, 1
    ds_add_u32 v9, v10 offset:0
    s_mov_b64 exec, -1
    s_waitcnt vmcnt(5)
    buffer_load_dwordx4 v[152:155], v2, s[32:35], s29 offen offset:2048 nt
    s_waitcnt vmcnt(5)
    buffer_load_dwordx4 v[156:159], v2, s[32:35], s29 offen offset:2176 nt
    s_waitcnt vmcnt(5)
    buffer_load_dwordx4 v[160:163], v2, s[32:35], s30 offen offset:0 nt
    s_waitcnt vmcnt(5)
    buffer_load_dwordx4 v[164:167], v2, s[32:35], s30 offen offset:128 nt
    s_mov_b64 exec, 1
    ds_add_u32 v9, v10 offset:20
    s_mov_b64 exec, -1
    s_waitcnt vmcnt(5)
    buffer_load_dwordx4 v[168:171], v2, s[32:35], s30 offen offset:2048 nt
    s_waitcnt vmcnt(5)
    buffer_load_dwordx4 v[172:175], v2, s[32:35], s30 offen offset:2176 nt
    s_mov_b64 exec, 1
    ds_add_u32 v9, v10 offset:20
    s_mov_b64 exec, -1
    s_waitcnt vmcnt(5)
    buffer_load_dwordx4 v[176:179], v2, s[32:35], s31 offen offset:0 nt
    s_waitcnt vmcnt(5)
    buffer_load_dwordx4 v[180:183], v2, s[32:35], s31 offen offset:128 nt
    s_mov_b64 exec, 1
    ds_add_u32 v9, v10 offset:20
    s_mov_b64 exec, -1
    s_waitcnt vmcnt(5)
    buffer_load_dwordx4 v[184:187], v2, s[32:35], s31 offen offset:2048 nt
    s_waitcnt vmcnt(5)
    buffer_load_dwordx4 v[188:191], v2, s[32:35], s31 offen offset:2176 nt
    s_mov_b64 exec, 1
    ds_add_u32 v9, v10 offset:20
    s_mov_b64 exec, -1
    s_waitcnt vmcnt(5)
    buffer_load_dwordx4 v[192:195], v3, s[36:39], s28 offen offset:0 nt
    s_waitcnt vmcnt(5)
    buffer_load_dwordx4 v[196:199], v3, s[36:39], s28 offen offset:1024 nt
    s_waitcnt vmcnt(5)
    buffer_load_dwordx4 v[200:203], v3, s[36:39], s28 offen offset:2048 nt
    s_waitcnt vmcnt(5)
    buffer_load_dwordx4 v[204:207], v3, s[36:39], s28 offen offset:3072 nt
    s_waitcnt vmcnt(5)
    buffer_load_dwordx4 v[208:211], v3, s[36:39], s29 offen offset:0 nt
    s_waitcnt vmcnt(5)
    buffer_load_dwordx4 v[212:215], v3, s[36:39], s29 offen offset:1024 nt
    s_waitcnt vmcnt(5)
    buffer_load_dwordx4 v[216:219], v3, s[36:39], s29 offen offset:2048 nt
    s_waitcnt vmcnt(5)
    buffer_load_dwordx4 v[220:223], v3, s[36:39], s29 offen offset:3072 nt
    v_perm_b32 v32, v196, v192, s52
    v_perm_b32 v36, v196, v192, s53
    v_perm_b32 v40, v197, v193, s52
    v_perm_b32 v44, v197, v193, s53
    v_perm_b32 v48, v198, v194, s52
    v_perm_b32 v52, v198, v194, s53
    v_perm_b32 v56, v199, v195, s52
    v_perm_b32 v60, v199, v195, s53
    s_waitcnt vmcnt(5)
    buffer_load_dwordx4 v[224:227], v3, s[36:39], s30 offen offset:0 nt
    s_waitcnt vmcnt(5)
    buffer_load_dwordx4 v[228:231], v3, s[36:39], s30 offen offset:1024 nt
    v_perm_b32 v33, v204, v200, s52
    v_perm_b32 v37, v204, v200, s53
    v_perm_b32 v41, v205, v201, s52
    v_perm_b32 v45, v205, v201, s53
    v_perm_b32 v49, v206, v202, s52
    v_perm_b32 v53, v206, v202, s53
    v_perm_b32 v57, v207, v203, s52
    v_perm_b32 v61, v207, v203, s53
    s_waitcnt vmcnt(5)
    buffer_load_dwordx4 v[232:235], v3, s[36:39], s30 offen offset:2048 nt
L_wq:
    ds_read_b32 v11, v9 offset:4
    ds_read_b32 v12, v9 offset:28
    ds_read_b128 v[16:19], v7 offset:1280
    ds_read_b128 v[20:23], v7 offset:1408
    s_waitcnt lgkmcnt(0)
    v_readfirstlane_b32 s10, v11
    v_readfirstlane_b32 s61, v12
    s_cmp_lt_u32 s10, 4
    s_cbranch_scc1 L_wq
    v_mfma_f32_16x16x32_bf16 v[96:99], v[128:131], v[16:19], 0
    v_mfma_f32_16x16x32_bf16 v[100:103], v[136:139], v[16:19], 0
    v_mfma_f32_16x16x32_bf16 v[104:107], v[144:147], v[16:19], 0
    v_mfma_f32_16x16x32_bf16 v[108:111], v[152:155], v[16:19], 0
    v_mfma_f32_16x16x32_bf16 v[112:115], v[160:163], v[16:19], 0
    v_mfma_f32_16x16x32_bf16 v[116:119], v[168:171], v[16:19], 0
    v_mfma_f32_16x16x32_bf16 v[120:123], v[176:179], v[16:19], 0
    v_mfma_f32_16x16x32_bf16 v[124:127], v[184:187], v[16:19], 0
    s_waitcnt vmcnt(5)
    buffer_load_dwordx4 v[236:239], v3, s[36:39], s30 offen offset:3072 nt
    v_perm_b32 v34, v212, v208, s52
    v_perm_b32 v38, v212, v208, s53
    v_perm_b32 v42, v213, v209, s52
    v_perm_b32 v46, v213, v209, s53
    v_perm_b32 v50, v214, v210, s52
    v_perm_b32 v54, v214, v210, s53
    v_perm_b32 v58, v215, v211, s52
    v_perm_b32 v62, v215, v211, s53
    v_mfma_f32_16x16x32_bf16 v[96:99], v[132:135], v[20:23], v[96:99]
    v_mfma_f32_16x16x32_bf16 v[100:103], v[140:143], v[20:23], v[100:103]
    v_mfma_f32_16x16x32_bf16 v[104:107], v[148:151], v[20:23], v[104:107]
    v_mfma_f32_16x16x32_bf16 v[108:111], v[156:159], v[20:23], v[108:111]
    v_mfma_f32_16x16x32_bf16 v[112:115], v[164:167], v[20:23], v[112:115]
    v_mfma_f32_16x16x32_bf16 v[116:119], v[172:175], v[20:23], v[116:119]
    v_mfma_f32_16x16x32_bf16 v[120:123], v[180:183], v[20:23], v[120:123]
    v_mfma_f32_16x16x32_bf16 v[124:127], v[188:191], v[20:23], v[124:127]
    s_waitcnt vmcnt(5)
    buffer_load_dwordx4 v[240:243], v3, s[36:39], s31 offen offset:0 nt
    s_nop 4
    v_add_f32_dpp v96, v96, v98 row_ror:8 row_mask:0xf bank_mask:0xc
    v_add_f32_dpp v97, v97, v99 row_ror:8 row_mask:0xf bank_mask:0xc
    v_add_f32_dpp v100, v100, v102 row_ror:8 row_mask:0xf bank_mask:0xc
    v_add_f32_dpp v101, v101, v103 row_ror:8 row_mask:0xf bank_mask:0xc
    v_add_f32_dpp v104, v104, v106 row_ror:8 row_mask:0xf bank_mask:0xc
    v_add_f32_dpp v105, v105, v107 row_ror:8 row_mask:0xf bank_mask:0xc
    v_add_f32_dpp v108, v108, v110 row_ror:8 row_mask:0xf bank_mask:0xc
    v_add_f32_dpp v109, v109, v111 row_ror:8 row_mask:0xf bank_mask:0xc
    v_add_f32_dpp v112, v112, v114 row_ror:8 row_mask:0xf bank_mask:0xc
    v_add_f32_dpp v113, v113, v115 row_ror:8 row_mask:0xf bank_mask:0xc
    v_add_f32_dpp v116, v116, v118 row_ror:8 row_mask:0xf bank_mask:0xc
    v_add_f32_dpp v117, v117, v119 row_ror:8 row_mask:0xf bank_mask:0xc
    v_add_f32_dpp v120, v120, v122 row_ror:8 row_mask:0xf bank_mask:0xc
    v_add_f32_dpp v121, v121, v123 row_ror:8 row_mask:0xf bank_mask:0xc
    v_add_f32_dpp v124, v124, v126 row_ror:8 row_mask:0xf bank_mask:0xc
    v_add_f32_dpp v125, v125, v127 row_ror:8 row_mask:0xf bank_mask:0xc
    v_add_f32_dpp v96, v98, v96 row_ror:8 row_mask:0xf bank_mask:0x3
    v_add_f32_dpp v97, v99, v97 row_ror:8 row_mask:0xf bank_mask:0x3
    v_add_f32_dpp v100, v102, v100 row_ror:8 row_mask:0xf bank_mask:0x3
    v_add_f32_dpp v101, v103, v101 row_ror:8 row_mask:0xf bank_mask:0x3
    v_add_f32_dpp v104, v106, v104 row_ror:8 row_mask:0xf bank_mask:0x3
    v_add_f32_dpp v105, v107, v105 row_ror:8 row_mask:0xf bank_mask:0x3
    v_add_f32_dpp v108, v110, v108 row_ror:8 row_mask:0xf bank_mask:0x3
    v_add_f32_dpp v109, v111, v109 row_ror:8 row_mask:0xf bank_mask:0x3
    v_add_f32_dpp v112, v114, v112 row_ror:8 row_mask:0xf bank_mask:0x3
    v_add_f32_dpp v113, v115, v113 row_ror:8 row_mask:0xf bank_mask:0x3
    v_add_f32_dpp v116, v118, v116 row_ror:8 row_mask:0xf bank_mask:0x3
    v_add_f32_dpp v117, v119, v117 row_ror:8 row_mask:0xf bank_mask:0x3
    v_add_f32_dpp v120, v122, v120 row_ror:8 row_mask:0xf bank_mask:0x3
    v_add_f32_dpp v121, v123, v121 row_ror:8 row_mask:0xf bank_mask:0x3
    v_add_f32_dpp v124, v126, v124 row_ror:8 row_mask:0xf bank_mask:0x3
    v_add_f32_dpp v125, v127, v125 row_ror:8 row_mask:0xf bank_mask:0x3
    s_waitcnt vmcnt(5)
    buffer_load_dwordx4 v[244:247], v3, s[36:39], s31 offen offset:1024 nt
    v_perm_b32 v35, v220, v216, s52
    v_perm_b32 v39, v220, v216, s53
    v_perm_b32 v43, v221, v217, s52
    v_perm_b32 v47, v221, v217, s53
    v_perm_b32 v51, v222, v218, s52
    v_perm_b32 v55, v222, v218, s53
    v_perm_b32 v59, v223, v219, s52
    v_perm_b32 v63, v223, v219, s53
    v_max3_f32 v24, v96, v97, v100
    v_max3_f32 v25, v101, v104, v105
    v_max3_f32 v24, v108, v109, v24
    v_max3_f32 v25, v112, v113, v25
    v_max3_f32 v24, v116, v117, v24
    v_max3_f32 v25, v120, v121, v25
    v_max3_f32 v24, v124, v125, v24
    v_max_f32 v24, v24, v25
    v_mov_b32 v25, v24
    s_nop 1
    v_permlane32_swap_b32 v25, v24
    s_nop 0
    v_max_f32 v24, v25, v24
    v_mov_b32 v25, v24
    s_nop 1
    v_permlane16_swap_b32 v25, v24
    s_nop 0
    v_max_f32 v24, v25, v24
    v_mul_f32 v24, s60, v24
    v_fma_f32 v96, v96, s60, -v24
    v_fma_f32 v97, v97, s60, -v24
    v_fma_f32 v100, v100, s60, -v24
    v_fma_f32 v101, v101, s60, -v24
    v_fma_f32 v104, v104, s60, -v24
    v_fma_f32 v105, v105, s60, -v24
    v_fma_f32 v108, v108, s60, -v24
    v_fma_f32 v109, v109, s60, -v24
    v_fma_f32 v112, v112, s60, -v24
    v_fma_f32 v113, v113, s60, -v24
    v_fma_f32 v116, v116, s60, -v24
    v_fma_f32 v117, v117, s60, -v24
    v_fma_f32 v120, v120, s60, -v24
    v_fma_f32 v121, v121, s60, -v24
    v_fma_f32 v124, v124, s60, -v24
    v_fma_f32 v125, v125, s60, -v24
    s_waitcnt vmcnt(5)
    buffer_load_dwordx4 v[248:251], v3, s[36:39], s31 offen offset:2048 nt
    v_exp_f32 v96, v96
    v_exp_f32 v97, v97
    v_exp_f32 v100, v100
    v_exp_f32 v101, v101
    v_exp_f32 v104, v104
    v_exp_f32 v105, v105
    v_exp_f32 v108, v108
    v_exp_f32 v109, v109
    v_exp_f32 v112, v112
    v_exp_f32 v113, v113
    v_exp_f32 v116, v116
    v_exp_f32 v117, v117
    v_exp_f32 v120, v120
    v_exp_f32 v121, v121
    v_exp_f32 v124, v124
    v_exp_f32 v125, v125
    s_waitcnt vmcnt(5)
    buffer_load_dwordx4 v[252:255], v3, s[36:39], s31 offen offset:3072 nt
    v_add_f32 v25, v96, v97
    v_add_f32 v26, v100, v101
    v_add_f32 v25, v25, v104
    v_add_f32 v26, v26, v105
    v_add_f32 v25, v25, v108
    v_add_f32 v26, v26, v109
    v_add_f32 v25, v25, v112
    v_add_f32 v26, v26, v113
    v_add_f32 v25, v25, v116
    v_add_f32 v26, v26, v117
    v_add_f32 v25, v25, v120
    v_add_f32 v26, v26, v121
    v_add_f32 v25, v25, v124
    v_add_f32 v26, v26, v125
    v_add_f32 v25, v25, v26
    v_mov_b32 v26, v25
    s_nop 1
    v_permlane32_swap_b32 v26, v25
    s_nop 0
    v_add_f32 v25, v26, v25
    v_mov_b32 v26, v25
    s_nop 1
    v_permlane16_swap_b32 v26, v25
    s_nop 0
    v_add_f32 v25, v26, v25
    s_mov_b64 exec, 0xff
    ds_write_b64 v29, v[24:25] offset:64
    s_mov_b64 exec, 1
    ds_add_u32 v9, v10 offset:8
    s_mov_b64 exec, -1
    v_perm_b32 v160, v228, v224, s52
    v_perm_b32 v164, v228, v224, s53
    v_perm_b32 v168, v229, v225, s52
    v_perm_b32 v172, v229, v225, s53
    v_perm_b32 v176, v230, v226, s52
    v_perm_b32 v180, v230, v226, s53
    v_perm_b32 v184, v231, v227, s52
    v_perm_b32 v188, v231, v227, s53
    s_waitcnt vmcnt(5)
    v_cvt_pk_bf16_f32 v98, v96, v97
    v_cvt_pk_bf16_f32 v102, v100, v101
    v_cvt_pk_bf16_f32 v106, v104, v105
    v_cvt_pk_bf16_f32 v110, v108, v109
    v_cvt_pk_bf16_f32 v114, v112, v113
    v_cvt_pk_bf16_f32 v118, v116, v117
    v_cvt_pk_bf16_f32 v122, v120, v121
    v_cvt_pk_bf16_f32 v126, v124, v125
    v_cndmask_b32 v128, v98, 0, s[56:57]
    v_cndmask_b32 v132, 0, v98, s[56:57]
    v_cndmask_b32 v129, v102, 0, s[56:57]
    v_cndmask_b32 v133, 0, v102, s[56:57]
    v_cndmask_b32 v130, v106, 0, s[56:57]
    v_cndmask_b32 v134, 0, v106, s[56:57]
    v_cndmask_b32 v131, v110, 0, s[56:57]
    v_cndmask_b32 v135, 0, v110, s[56:57]
    v_cndmask_b32 v136, v114, 0, s[56:57]
    v_cndmask_b32 v140, 0, v114, s[56:57]
    v_cndmask_b32 v137, v118, 0, s[56:57]
    v_cndmask_b32 v141, 0, v118, s[56:57]
    v_cndmask_b32 v138, v122, 0, s[56:57]
    v_cndmask_b32 v142, 0, v122, s[56:57]
    v_cndmask_b32 v139, v126, 0, s[56:57]
    v_cndmask_b32 v143, 0, v126, s[56:57]
    s_waitcnt vmcnt(4)
    buffer_load_dwordx4 v[64:67], v4, s[44:47], 0 offen offset:0 nt
    s_nop 1
    v_mfma_f32_16x16x32_bf16 v[144:147], v[32:35], v[128:131], 0
    v_mfma_f32_16x16x32_bf16 v[148:151], v[36:39], v[128:131], 0
    v_mfma_f32_16x16x32_bf16 v[152:155], v[40:43], v[128:131], 0
    v_mfma_f32_16x16x32_bf16 v[156:159], v[44:47], v[128:131], 0
    v_mfma_f32_16x16x32_bf16 v[144:147], v[48:51], v[132:135], v[144:147]
    v_mfma_f32_16x16x32_bf16 v[148:151], v[52:55], v[132:135], v[148:151]
    v_mfma_f32_16x16x32_bf16 v[152:155], v[56:59], v[132:135], v[152:155]
    v_mfma_f32_16x16x32_bf16 v[156:159], v[60:63], v[132:135], v[156:159]
    v_perm_b32 v161, v236, v232, s52
    v_perm_b32 v165, v236, v232, s53
    v_perm_b32 v169, v237, v233, s52
    v_perm_b32 v173, v237, v233, s53
    v_perm_b32 v177, v238, v234, s52
    v_perm_b32 v181, v238, v234, s53
    v_perm_b32 v185, v239, v235, s52
    v_perm_b32 v189, v239, v235, s53
    s_waitcnt vmcnt(4)
    buffer_load_dwordx4 v[68:71], v4, s[44:47], 0 offen offset:2048 nt
    s_waitcnt vmcnt(4)
    s_movk_i32 s58, 0x1000
    buffer_load_dwordx4 v[72:75], v4, s[44:47], s58 offen offset:0 nt
    v_perm_b32 v162, v244, v240, s52
    v_perm_b32 v166, v244, v240, s53
    v_perm_b32 v170, v245, v241, s52
    v_perm_b32 v174, v245, v241, s53
    v_perm_b32 v178, v246, v242, s52
    v_perm_b32 v182, v246, v242, s53
    v_perm_b32 v186, v247, v243, s52
    v_perm_b32 v190, v247, v243, s53
    s_waitcnt vmcnt(4)
    buffer_load_dwordx4 v[76:79], v4, s[44:47], s58 offen offset:2048 nt
    s_waitcnt vmcnt(4)
    s_movk_i32 s58, 0x2000
    buffer_load_dwordx4 v[80:83], v4, s[44:47], s58 offen offset:0 nt
    v_perm_b32 v163, v252, v248, s52
    v_perm_b32 v167, v252, v248, s53
    v_perm_b32 v171, v253, v249, s52
    v_perm_b32 v175, v253, v249, s53
    v_perm_b32 v179, v254, v250, s52
    v_perm_b32 v183, v254, v250, s53
    v_perm_b32 v187, v255, v251, s52
    v_perm_b32 v191, v255, v251, s53
    s_nop 1
    v_mfma_f32_16x16x32_bf16 v[144:147], v[160:163], v[136:139], v[144:147]
    v_mfma_f32_16x16x32_bf16 v[148:151], v[164:167], v[136:139], v[148:151]
    v_mfma_f32_16x16x32_bf16 v[152:155], v[168:171], v[136:139], v[152:155]
    v_mfma_f32_16x16x32_bf16 v[156:159], v[172:175], v[136:139], v[156:159]
    v_mfma_f32_16x16x32_bf16 v[144:147], v[176:179], v[140:143], v[144:147]
    v_mfma_f32_16x16x32_bf16 v[148:151], v[180:183], v[140:143], v[148:151]
    v_mfma_f32_16x16x32_bf16 v[152:155], v[184:187], v[140:143], v[152:155]
    v_mfma_f32_16x16x32_bf16 v[156:159], v[188:191], v[140:143], v[156:159]
    s_nop 4
    ds_write_b128 v28, v[144:147] offset:8192
    ds_write_b128 v28, v[148:151] offset:9504
    ds_write_b128 v28, v[152:155] offset:10816
    ds_write_b128 v28, v[156:159] offset:12128
    s_mov_b64 exec, 1
    ds_add_u32 v9, v10 offset:12
    s_mov_b64 exec, -1
    ds_read_b32 v11, v9 offset:24
    s_waitcnt lgkmcnt(0)
    v_readfirstlane_b32 s10, v11
    s_cmp_ge_u32 s10, 2
    s_cbranch_scc1 L_bu53
    ds_read_b32 v11, v9 offset:24
    s_waitcnt vmcnt(4)
L_bu53:
    buffer_load_dwordx4 v[84:87], v4, s[44:47], s58 offen offset:2048 nt
    s_waitcnt lgkmcnt(0)
    v_readfirstlane_b32 s10, v11
    s_cmp_ge_u32 s10, 2
    s_cbranch_scc1 L_bu54
    ds_read_b32 v11, v9 offset:24
    s_waitcnt vmcnt(4)
L_bu54:
    s_movk_i32 s58, 0x3000
    buffer_load_dwordx4 v[88:91], v4, s[44:47], s58 offen offset:0 nt
    s_waitcnt lgkmcnt(0)
    v_readfirstlane_b32 s10, v11
    s_cmp_ge_u32 s10, 2
    s_cbranch_scc1 L_bu55
    ds_read_b32 v11, v9 offset:24
    s_waitcnt vmcnt(4)
L_bu55:
    buffer_load_dwordx4 v[92:95], v4, s[44:47], s58 offen offset:2048 nt
    s_waitcnt lgkmcnt(0)
    v_readfirstlane_b32 s10, v11
    s_cmp_ge_u32 s10, 2
    s_cbranch_scc1 L_bu56
    ds_read_b32 v11, v9 offset:24
    s_waitcnt vmcnt(3)
L_bu56:
    s_mov_b32 s58, 0x20000
    buffer_load_dwordx4 v[96:99], v4, s[44:47], s58 offen offset:0 nt
    s_waitcnt lgkmcnt(0)
    v_readfirstlane_b32 s10, v11
    s_cmp_ge_u32 s10, 2
    s_cbranch_scc1 L_bu57
    ds_read_b32 v11, v9 offset:24
    s_waitcnt vmcnt(3)
L_bu57:
    buffer_load_dwordx4 v[100:103], v4, s[44:47], s58 offen offset:2048 nt
    s_waitcnt lgkmcnt(0)
    v_readfirstlane_b32 s10, v11
    s_cmp_ge_u32 s10, 2
    s_cbranch_scc1 L_bu58
    ds_read_b32 v11, v9 offset:24
    s_waitcnt vmcnt(3)
L_bu58:
    s_mov_b32 s58, 0x21000
    buffer_load_dwordx4 v[104:107], v4, s[44:47], s58 offen offset:0 nt
    s_waitcnt lgkmcnt(0)
    v_readfirstlane_b32 s10, v11
    s_cmp_ge_u32 s10, 2
    s_cbranch_scc1 L_bu59
    ds_read_b32 v11, v9 offset:24
    s_waitcnt vmcnt(3)
L_bu59:
    buffer_load_dwordx4 v[108:111], v4, s[44:47], s58 offen offset:2048 nt
    s_waitcnt lgkmcnt(0)
    v_readfirstlane_b32 s10, v11
    s_cmp_ge_u32 s10, 2
    s_cbranch_scc1 L_bu60
    ds_read_b32 v11, v9 offset:24
    s_waitcnt vmcnt(3)
L_bu60:
    s_mov_b32 s58, 0x22000
    buffer_load_dwordx4 v[112:115], v4, s[44:47], s58 offen offset:0 nt
    s_waitcnt lgkmcnt(0)
    v_readfirstlane_b32 s10, v11
    s_cmp_ge_u32 s10, 2
    s_cbranch_scc1 L_bu61
    ds_read_b32 v11, v9 offset:24
    s_waitcnt vmcnt(3)
L_bu61:
    buffer_load_dwordx4 v[116:119], v4, s[44:47], s58 offen offset:2048 nt
    s_waitcnt lgkmcnt(0)
    v_readfirstlane_b32 s10, v11
    s_cmp_ge_u32 s10, 2
    s_cbranch_scc1 L_bu62
    ds_read_b32 v11, v9 offset:24
    s_waitcnt vmcnt(3)
L_bu62:
    s_mov_b32 s58, 0x23000
    buffer_load_dwordx4 v[120:123], v4, s[44:47], s58 offen offset:0 nt
    s_waitcnt lgkmcnt(0)
    v_readfirstlane_b32 s10, v11
    s_cmp_ge_u32 s10, 2
    s_cbranch_scc1 L_bu63
    ds_read_b32 v11, v9 offset:24
    s_waitcnt vmcnt(3)
L_bu63:
    buffer_load_dwordx4 v[124:127], v4, s[44:47], s58 offen offset:2048 nt
    s_waitcnt vmcnt(14)
    v_perm_b32 v32, v68, v64, s52
    v_perm_b32 v36, v68, v64, s53
    v_perm_b32 v40, v69, v65, s52
    v_perm_b32 v44, v69, v65, s53
    v_perm_b32 v48, v70, v66, s52
    v_perm_b32 v52, v70, v66, s53
    v_perm_b32 v56, v71, v67, s52
    v_perm_b32 v60, v71, v67, s53
    s_waitcnt vmcnt(12)
    v_perm_b32 v33, v76, v72, s52
    v_perm_b32 v37, v76, v72, s53
    v_perm_b32 v41, v77, v73, s52
    v_perm_b32 v45, v77, v73, s53
    v_perm_b32 v49, v78, v74, s52
    v_perm_b32 v53, v78, v74, s53
    v_perm_b32 v57, v79, v75, s52
    v_perm_b32 v61, v79, v75, s53
    s_waitcnt vmcnt(10)
    v_perm_b32 v34, v84, v80, s52
    v_perm_b32 v38, v84, v80, s53
    v_perm_b32 v42, v85, v81, s52
    v_perm_b32 v46, v85, v81, s53
    v_perm_b32 v50, v86, v82, s52
    v_perm_b32 v54, v86, v82, s53
    v_perm_b32 v58, v87, v83, s52
    v_perm_b32 v62, v87, v83, s53
    s_waitcnt vmcnt(8)
    v_perm_b32 v35, v92, v88, s52
    v_perm_b32 v39, v92, v88, s53
    v_perm_b32 v43, v93, v89, s52
    v_perm_b32 v47, v93, v89, s53
    v_perm_b32 v51, v94, v90, s52
    v_perm_b32 v55, v94, v90, s53
    v_perm_b32 v59, v95, v91, s52
    v_perm_b32 v63, v95, v91, s53
    s_waitcnt vmcnt(6)
    v_perm_b32 v160, v100, v96, s52
    v_perm_b32 v164, v100, v96, s53
    v_perm_b32 v168, v101, v97, s52
    v_perm_b32 v172, v101, v97, s53
    v_perm_b32 v176, v102, v98, s52
    v_perm_b32 v180, v102, v98, s53
    v_perm_b32 v184, v103, v99, s52
    v_perm_b32 v188, v103, v99, s53
    s_waitcnt vmcnt(4)
    v_perm_b32 v161, v108, v104, s52
    v_perm_b32 v165, v108, v104, s53
    v_perm_b32 v169, v109, v105, s52
    v_perm_b32 v173, v109, v105, s53
    v_perm_b32 v177, v110, v106, s52
    v_perm_b32 v181, v110, v106, s53
    v_perm_b32 v185, v111, v107, s52
    v_perm_b32 v189, v111, v107, s53
    s_waitcnt vmcnt(2)
    ds_read_b32 v11, v9 offset:16
    ds_read_b128 v[16:19], v8 offset:512
    ds_read_b128 v[20:23], v8 offset:640
    v_perm_b32 v162, v116, v112, s52
    v_perm_b32 v166, v116, v112, s53
    v_perm_b32 v170, v117, v113, s52
    v_perm_b32 v174, v117, v113, s53
    v_perm_b32 v178, v118, v114, s52
    v_perm_b32 v182, v118, v114, s53
    v_perm_b32 v186, v119, v115, s52
    v_perm_b32 v190, v119, v115, s53
    s_waitcnt lgkmcnt(0)
    v_readfirstlane_b32 s10, v11
    s_cmp_lt_u32 s10, 2
    s_cbranch_scc1 L_noeb
    v_mfma_f32_16x16x32_bf16 v[192:195], v[16:19], v[32:35], 0
    v_mfma_f32_16x16x32_bf16 v[208:211], v[16:19], v[48:51], 0
    v_mfma_f32_16x16x32_bf16 v[196:199], v[16:19], v[36:39], 0
    v_mfma_f32_16x16x32_bf16 v[212:215], v[16:19], v[52:55], 0
    v_mfma_f32_16x16x32_bf16 v[200:203], v[16:19], v[40:43], 0
    v_mfma_f32_16x16x32_bf16 v[216:219], v[16:19], v[56:59], 0
    v_mfma_f32_16x16x32_bf16 v[204:207], v[16:19], v[44:47], 0
    v_mfma_f32_16x16x32_bf16 v[220:223], v[16:19], v[60:63], 0
L_noeb:
    s_waitcnt vmcnt(0)
    v_perm_b32 v163, v124, v120, s52
    v_perm_b32 v167, v124, v120, s53
    v_perm_b32 v171, v125, v121, s52
    v_perm_b32 v175, v125, v121, s53
    v_perm_b32 v179, v126, v122, s52
    v_perm_b32 v183, v126, v122, s53
    v_perm_b32 v187, v127, v123, s52
    v_perm_b32 v191, v127, v123, s53
    s_cbranch_scc0 L_eb
L_wo:
    ds_read_b32 v11, v9 offset:16
    ds_read_b128 v[16:19], v8 offset:512
    ds_read_b128 v[20:23], v8 offset:640
    s_waitcnt lgkmcnt(0)
    v_readfirstlane_b32 s10, v11
    s_cmp_lt_u32 s10, 2
    s_cbranch_scc1 L_wo
    v_mfma_f32_16x16x32_bf16 v[192:195], v[16:19], v[32:35], 0
    v_mfma_f32_16x16x32_bf16 v[208:211], v[16:19], v[48:51], 0
    v_mfma_f32_16x16x32_bf16 v[196:199], v[16:19], v[36:39], 0
    v_mfma_f32_16x16x32_bf16 v[212:215], v[16:19], v[52:55], 0
    v_mfma_f32_16x16x32_bf16 v[200:203], v[16:19], v[40:43], 0
    v_mfma_f32_16x16x32_bf16 v[216:219], v[16:19], v[56:59], 0
    v_mfma_f32_16x16x32_bf16 v[204:207], v[16:19], v[44:47], 0
    v_mfma_f32_16x16x32_bf16 v[220:223], v[16:19], v[60:63], 0
L_eb:
    s_cmp_lg_u32 s61, 0
    v_mfma_f32_16x16x32_bf16 v[192:195], v[20:23], v[160:163], v[192:195]
    v_mfma_f32_16x16x32_bf16 v[208:211], v[20:23], v[176:179], v[208:211]
    v_mfma_f32_16x16x32_bf16 v[196:199], v[20:23], v[164:167], v[196:199]
    v_mfma_f32_16x16x32_bf16 v[212:215], v[20:23], v[180:183], v[212:215]
    v_mfma_f32_16x16x32_bf16 v[200:203], v[20:23], v[168:171], v[200:203]
    v_mfma_f32_16x16x32_bf16 v[216:219], v[20:23], v[184:187], v[216:219]
    v_mfma_f32_16x16x32_bf16 v[204:207], v[20:23], v[172:175], v[204:207]
    v_mfma_f32_16x16x32_bf16 v[220:223], v[20:23], v[188:191], v[220:223]
    s_nop 1
    v_cndmask_b32 v24, v192, v208, s[54:55]
    v_cndmask_b32 v12, v193, v209, s[54:55]
    v_cndmask_b32 v25, v196, v212, s[54:55]
    v_cndmask_b32 v13, v197, v213, s[54:55]
    v_cndmask_b32 v26, v200, v216, s[54:55]
    v_cndmask_b32 v14, v201, v217, s[54:55]
    v_cndmask_b32 v27, v204, v220, s[54:55]
    v_cndmask_b32 v15, v205, v221, s[54:55]
    v_add_f32_dpp v24, v12, v24 row_ror:8 row_mask:0xf bank_mask:0xf
    v_add_f32_dpp v25, v13, v25 row_ror:8 row_mask:0xf bank_mask:0xf
    v_add_f32_dpp v26, v14, v26 row_ror:8 row_mask:0xf bank_mask:0xf
    v_add_f32_dpp v27, v15, v27 row_ror:8 row_mask:0xf bank_mask:0xf
    s_mov_b64 exec, s[24:25]
    v_bfi_b32 v24, v31, s20, v24
    v_bfi_b32 v25, v31, s21, v25
    v_bfi_b32 v26, v31, s22, v26
    v_bfi_b32 v27, v31, s23, v27
    s_cbranch_scc1 L_srem
    buffer_store_dwordx4 v[24:27], v30, s[48:51], s59 offen
L_finS:
    s_mov_b64 exec, 1
    ds_add_u32 v9, v10 offset:40
    s_endpgm
L_srem:
    buffer_store_dwordx4 v[24:27], v30, s[48:51], s59 offen sc1
    s_branch L_finS
L_helper:
    s_setprio 3
    s_load_dwordx2 s[12:13], s[0:1], s5 offset:0
    s_load_dwordx2 s[24:25], s[0:1], 80
    v_lshrrev_b32 v11, 6, v0
    v_and_b32 v1, 63, v0
    s_and_b32 s10, s2, 7
    v_readfirstlane_b32 s3, v11
    v_lshlrev_b32 v2, 4, v1
    s_lshr_b32 s7, s2, 3
    s_lshl_b32 s50, 1, 21
    s_mov_b32 s51, s43
    s_sub_u32 s3, s3, 4
    s_lshl_b32 s11, s10, 5
    s_or_b32 s11, s11, s7
    s_and_b32 s19, s11, 0xfc
    s_lshl_b32 s19, s19, 1
    s_and_b32 s16, s7, 3
    s_or_b32 s19, s19, s16
    s_lshl_b32 s19, s19, 1
    s_and_b32 s22, s3, 1
    s_or_b32 s19, s19, s22
    s_lshl_b32 s19, s19, 10
    s_add_u32 s19, s19, 0x100000
    s_waitcnt lgkmcnt(0)
    s_cmp_lt_u32 s3, 2
    s_cbranch_scc1 L_norace
    s_lshl_b32 s16, s22, 13
    s_xor_b32 s16, s16, s19
    s_xor_b32 s17, s16, 0x2000
    s_mov_b32 s21, 0
    s_mov_b32 s64, 0x5a3c96e1
    s_mov_b32 s65, s64
    s_not_b64 s[66:67], s[64:65]
    s_not_b64 s[64:65], s[64:65]
    s_load_dword s64, s[48:49], s16 glc
    s_load_dword s65, s[48:49], s17 glc
    s_waitcnt lgkmcnt(1)
    s_waitcnt lgkmcnt(0)
    s_not_b64 s[66:67], s[64:65]
    s_not_b64 s[64:65], s[64:65]
    s_load_dword s64, s[48:49], s16 glc
    s_load_dword s65, s[48:49], s17 glc
    s_waitcnt lgkmcnt(1)
    s_mov_b64 s[68:69], s[64:65]
    s_cmp_lg_u32 s68, s66
    s_addc_u32 s21, s21, 0
    s_cmp_lg_u32 s69, s67
    s_subb_u32 s21, s21, 0
    s_waitcnt lgkmcnt(0)
    s_not_b64 s[66:67], s[64:65]
    s_not_b64 s[64:65], s[64:65]
    s_load_dword s64, s[48:49], s16 glc
    s_load_dword s65, s[48:49], s17 glc
    s_waitcnt lgkmcnt(1)
    s_mov_b64 s[68:69], s[64:65]
    s_cmp_lg_u32 s68, s66
    s_addc_u32 s21, s21, 0
    s_cmp_lg_u32 s69, s67
    s_subb_u32 s21, s21, 0
    s_waitcnt lgkmcnt(0)
    s_getreg_b32 s17, hwreg(HW_REG_XCC_ID, 0, 4)
    s_and_b32 s16, s2, 3
    s_sub_u32 s16, s17, s16
    s_add_u32 s16, s16, 1
    s_xor_b32 s16, s16, s17
    s_bfe_u32 s16, s16, 0x10002
    s_xor_b32 s16, s16, s22
    s_lshl_b32 s16, s16, 1
    s_sub_u32 s16, 1, s16
    s_mul_i32 s21, s21, s16
    v_mov_b32 v12, s21
    s_mov_b64 exec, 1
    ds_add_u32 v9, v12 offset:44
    s_mov_b64 exec, -1
L_norace:
    s_load_dwordx2 s[8:9], s[48:49], s14 offset:0x40000
    s_load_dwordx2 s[26:27], s[12:13], 0
    v_lshrrev_b32 v13, 4, v1
    s_and_b32 s6, s2, 3
    v_mov_b32 v10, 1
    s_mov_b32 s52, 0x05040100
    s_mov_b32 s53, 0x07060302
    v_lshrrev_b32 v4, 5, v1
    v_and_b32 v5, 31, v1
    v_lshlrev_b32 v3, 10, v4
    v_lshl_or_b32 v3, v5, 4, v3
    s_lshr_b32 s16, s7, 4
    s_lshl_b32 s16, s16, 9
    v_or_b32 v3, s16, v3
    s_lshl_b32 s14, s10, 15
    s_lshl_b32 s15, s3, 13
    s_or_b32 s14, s14, s15
    s_add_u32 s15, s14, 4096
    v_and_b32 v12, 15, v1
    v_lshlrev_b32 v30, 7, v12
    v_lshlrev_b32 v4, 2, v4
    v_lshl_or_b32 v4, v5, 3, v4
    s_mul_i32 s16, s3, 544
    v_add_u32 v4, s16, v4
    s_lshl_b32 s16, s3, 2
    v_add_u32 v14, s16, v13
    v_lshlrev_b32 v5, 5, v14
    v_lshlrev_b32 v7, 8, v14
    v_lshlrev_b32 v6, 4, v14
    v_and_b32 v15, 1, v1
    v_mul_u32_u24 v15, 2624, v15
    v_add_u32 v6, v6, v15
    v_bfe_u32 v15, v1, 1, 1
    v_lshl_add_u32 v6, v15, 7, v6
    v_bfe_u32 v15, v1, 2, 2
    v_mul_u32_u24 v15, 272, v15
    v_add_u32 v6, v6, v15
    s_lshl_b32 s17, s4, 12
    s_add_u32 s17, s17, 0x48000
    s_lshl_b32 s5, s6, 11
    s_lshl_b32 s16, s7, 3
    s_or_b32 s5, s5, s16
    s_add_u32 s5, s5, s17
    s_lshl_b32 s20, s7, 1
    s_or_b32 s20, s20, s22
    s_lshl_b32 s20, s20, 7
    s_add_u32 s20, s20, s17
    v_lshlrev_b32 v8, 14, v13
    v_lshl_or_b32 v8, v12, 4, v8
    s_lshr_b32 s21, s7, 3
    s_or_b32 s28, s4, s21
    s_lshl_b32 s28, s28, 1
    s_or_b32 s28, s28, s22
    s_lshl_b32 s28, s28, 8
    s_and_b32 s21, s7, 7
    s_or_b32 s28, s28, s21
    s_lshl_b32 s28, s28, 8
    s_add_u32 s28, s28, 0x100000
    s_add_u32 s29, s28, 4096
    v_and_b32 v15, 3, v1
    v_lshlrev_b32 v23, 4, v15
    v_lshl_add_u32 v23, v13, 6, v23
    s_mul_i32 s16, s22, 384
    v_add_u32 v23, s16, v23
    s_lshl_b32 s16, s3, 5
    v_lshl_add_u32 v20, v1, 1, s16
    v_lshl_add_u32 v22, v13, 3, s16
    s_lshl_b32 s16, s22, 2
    v_mov_b32 v21, s16
    s_mul_i32 s32, s11, 2176
    s_add_u32 s32, s32, 0x50000
    v_and_b32 v15, 3, v1
    s_lshr_b32 s21, s7, 3
    v_lshlrev_b32 v25, 3, v15
    v_lshl_or_b32 v25, v13, 1, v25
    s_lshl_b32 s21, s21, 7
    s_lshl_b32 s22, s6, 9
    s_or_b32 s21, s21, s22
    s_lshl_b32 s22, s4, 9
    s_or_b32 s21, s21, s22
    s_bfe_u32 s22, s7, 0x10002
    s_lshl_b32 s22, s22, 12
    s_or_b32 s21, s21, s22
    s_and_b32 s22, s7, 3
    s_lshl_b32 s22, s22, 5
    s_or_b32 s21, s21, s22
    v_or_b32 v25, s21, v25
    s_getreg_b32 s33, hwreg(HW_REG_XCC_ID, 0, 4)
    s_waitcnt lgkmcnt(0)
    s_xor_b64 s[26:27], s[26:27], s[8:9]
    s_mul_i32 s16, s26, 0x9e3779b1
    s_xor_b32 s16, s16, s27
    s_mul_hi_u32 s17, s16, 0x85ebca6b
    s_mul_i32 s16, s16, 0x85ebca6b
    s_xor_b32 s16, s16, s17
    s_mul_hi_u32 s17, s16, 0xc2b2ae35
    s_or_b32 s16, s16, 0x11311911
    s_or_b32 s17, s17, 0x200801
    s_xor_b32 s8, s8, s16
    s_xor_b32 s9, s9, s17
    s_and_b32 s60, s8, 0x7ff
    s_bfe_u32 s61, s8, 0xb000b
    s_and_b32 s62, s9, 0x7ff
    s_bfe_u32 s63, s9, 0xb000b
    s_andn2_b32 s18, s63, 63
    s_or_b32 s18, s18, s33
    s_mov_b32 s33, 0
    v_lshlrev_b32 v15, 3, v15
    v_lshrrev_b32 v14, v15, s8
    s_mov_b32 s21, 0x10001
    v_mov_b32 v114, s21
    v_bfe_u32 v15, v14, 0, 2
    v_mul_u32_u24 v15, 0x8001, v15
    v_and_b32 v108, s21, v15
    v_bfe_u32 v15, v14, 2, 2
    v_mul_u32_u24 v15, 0x8001, v15
    v_and_b32 v109, s21, v15
    v_bfe_u32 v15, v14, 4, 2
    v_mul_u32_u24 v15, 0x8001, v15
    v_and_b32 v110, s21, v15
    v_bfe_u32 v15, v14, 6, 2
    v_mul_u32_u24 v15, 0x8001, v15
    v_and_b32 v111, s21, v15
    s_lshl_b32 s16, s3, 2
    s_add_u32 s16, s16, 4
    s_cmp_lg_u32 s3, 0
    s_cbranch_scc1 L_hq
    v_mov_b32 v31, 0xfff
    s_or_b32 s21, s60, 0x800
    v_mov_b32 v16, s21
    s_or_b32 s21, s61, 0x800
    v_mov_b32 v17, s21
    s_or_b32 s21, s62, 0x800
    v_mov_b32 v18, s21
    s_or_b32 s21, s18, 0x800
    v_mov_b32 v19, s21
    s_lshl_b32 s23, s11, 10
L_hp1:
    ds_read_b32 v11, v9 offset:0
    ds_read_b32 v12, v9 offset:44
    ds_read_b128 v[32:35], v2 offset:4096
    ds_read_b128 v[36:39], v2 offset:5120
    ds_read_b128 v[40:43], v2 offset:6144
    ds_read_b128 v[44:47], v2 offset:7168
    s_waitcnt lgkmcnt(0)
    v_readfirstlane_b32 s21, v11
    s_cmp_lt_u32 s21, 4
    s_cbranch_scc1 L_hp1
    v_readfirstlane_b32 s21, v12
    s_max_i32 s21, s21, -1
    s_min_i32 s21, s21, 1
    s_and_b32 s21, s21, 3
    v_lshl_or_b32 v19, s21, 4, v19
    v_pk_add_f32 v[32:33], v[32:33], v[36:37]
    v_pk_add_f32 v[34:35], v[34:35], v[38:39]
    v_pk_add_f32 v[40:41], v[40:41], v[44:45]
    v_pk_add_f32 v[42:43], v[42:43], v[46:47]
    v_pk_add_f32 v[48:49], v[32:33], v[40:41]
    v_pk_add_f32 v[50:51], v[34:35], v[42:43]
    v_bfi_b32 v104, v31, v16, v48
    v_bfi_b32 v105, v31, v17, v49
    v_bfi_b32 v106, v31, v18, v50
    v_bfi_b32 v107, v31, v19, v51
    buffer_store_dwordx4 v[104:107], v2, s[48:51], s23 offen
L_hq:
    ds_read_b32 v11, v9 offset:20
    s_waitcnt lgkmcnt(0)
    v_readfirstlane_b32 s21, v11
    s_cmp_lt_u32 s21, s16
    s_cbranch_scc1 L_hq
    s_mov_b32 s17, 0
L_hq1:
    buffer_load_dwordx4 v[32:35], v3, s[48:51], s14 offen sc1
    buffer_load_dwordx4 v[36:39], v3, s[48:51], s14 offen offset:2048 sc1
    buffer_load_dwordx4 v[40:43], v3, s[48:51], s15 offen sc1
    buffer_load_dwordx4 v[44:47], v3, s[48:51], s15 offen offset:2048 sc1
    s_waitcnt vmcnt(0)
    v_xor_b32 v32, s60, v32
    v_xor_b32 v33, s61, v33
    v_xor_b32 v34, s62, v34
    v_xor_b32 v35, s18, v35
    v_or3_b32 v11, v32, v33, v34
    v_xor_b32 v36, s60, v36
    v_xor_b32 v37, s61, v37
    v_xor_b32 v38, s62, v38
    v_xor_b32 v39, s18, v39
    v_or3_b32 v11, v36, v37, v11
    v_or_b32 v14, v34, v38
    v_or_b32 v12, v35, v39
    v_xor_b32 v40, s60, v40
    v_xor_b32 v41, s61, v41
    v_xor_b32 v42, s62, v42
    v_xor_b32 v43, s18, v43
    v_or3_b32 v11, v40, v41, v11
    v_xor_b32 v44, s60, v44
    v_xor_b32 v45, s61, v45
    v_xor_b32 v46, s62, v46
    v_xor_b32 v47, s18, v47
    v_or3_b32 v11, v44, v45, v11
    v_or3_b32 v14, v42, v46, v14
    v_or3_b32 v12, v43, v47, v12
    v_or_b32 v11, v11, v14
    v_and_b32 v12, 0x7cf, v12
    v_and_b32 v11, 0x7ff, v11
    v_or_b32 v14, v11, v12
    v_cmp_ne_u32 vcc, 0, v14
    s_cbranch_vccnz L_qslow
L_hq3:
    v_bfe_i32 v11, v35, 4, 2
    v_bfe_i32 v12, v39, 4, 2
    v_bfe_i32 v14, v43, 4, 2
    v_bfe_i32 v15, v47, 4, 2
    v_add3_u32 v11, v11, v12, v14
    v_add_u32 v11, v11, v15
    s_mov_b32 exec_lo, 1
    s_mov_b32 exec_hi, 1
    ds_add_u32 v9, v11 offset:48
    s_mov_b64 exec, -1
    v_and_b32 v35, 0xffffffc0, v35
    v_and_b32 v39, 0xffffffc0, v39
    v_and_b32 v43, 0xffffffc0, v43
    v_and_b32 v47, 0xffffffc0, v47
    v_pk_add_f32 v[32:33], v[32:33], v[36:37]
    v_pk_add_f32 v[34:35], v[34:35], v[38:39]
    v_pk_add_f32 v[40:41], v[40:41], v[44:45]
    v_pk_add_f32 v[42:43], v[42:43], v[46:47]
    s_nop 0
    v_permlane32_swap_b32 v32, v34
    v_permlane32_swap_b32 v33, v35
    v_permlane32_swap_b32 v40, v42
    v_permlane32_swap_b32 v41, v43
    s_nop 0
    v_pk_add_f32 v[32:33], v[32:33], v[34:35]
    v_pk_add_f32 v[40:41], v[40:41], v[42:43]
    v_cvt_pk_bf16_f32 v32, v32, v33
    v_cvt_pk_bf16_f32 v40, v40, v41
    ds_write_b32 v4, v32 offset:1280
    ds_write_b32 v4, v40 offset:1552
    s_mov_b64 exec, 1
    ds_add_u32 v9, v10 offset:4
    s_mov_b64 exec, -1
    s_cmp_ge_u32 s3, 2
    s_cbranch_scc1 L_h23
    s_or_b32 s33, s33, s3
L_hst:
    ds_read_b32 v11, v9 offset:8
    ds_read_b32 v12, v9 offset:32
    ds_read_b32 v14, v9 offset:48
    ds_read_b128 v[32:35], v5 offset:64
    ds_read_b128 v[36:39], v5 offset:80
    s_waitcnt lgkmcnt(0)
    v_readfirstlane_b32 s22, v12
    v_readfirstlane_b32 s21, v11
    s_cmp_lg_u32 s22, 0
    s_cbranch_scc1 L_repub
L_hst1:
    s_cmp_lt_u32 s21, 4
    s_cbranch_scc1 L_hst
    v_readfirstlane_b32 s22, v14
    s_cmp_ge_i32 s22, 0
    s_cselect_b32 s22, 0, 0x2000
    s_or_b32 s19, s19, s22
    s_or_b32 s5, s5, s22
    s_or_b32 s20, s20, s22
    s_xor_b32 s20, s20, 0x2000
    v_max3_f32 v11, v32, v34, v36
    v_max_f32 v11, v11, v38
    v_sub_f32 v26, v32, v11
    v_sub_f32 v27, v34, v11
    v_sub_f32 v28, v36, v11
    v_sub_f32 v29, v38, v11
    v_exp_f32 v26, v26
    v_exp_f32 v27, v27
    v_exp_f32 v28, v28
    v_exp_f32 v29, v29
    v_mul_f32 v12, v26, v33
    v_fmac_f32 v12, v27, v35
    v_fmac_f32 v12, v28, v37
    v_fmac_f32 v12, v29, v39
    v_log_f32 v14, v12
    v_rcp_f32 v12, v12
    v_mov_b32 v16, 0xff
    v_add_f32 v14, v14, v11
    v_mov_b32 v15, s9
    v_bfi_b32 v14, v16, s8, v14
    s_mov_b32 s56, 0x00010001
    s_mov_b32 s57, 0x00010001
    v_mul_f32 v26, v26, v12
    v_mul_f32 v27, v27, v12
    v_mul_f32 v28, v28, v12
    v_mul_f32 v29, v29, v12
L_hpv:
    ds_read_b32 v11, v9 offset:12
    ds_read_b128 v[32:35], v6 offset:8192
    ds_read_b128 v[36:39], v6 offset:9504
    ds_read_b128 v[40:43], v6 offset:13440
    ds_read_b128 v[44:47], v6 offset:14752
    ds_read_b128 v[48:51], v6 offset:18688
    ds_read_b128 v[52:55], v6 offset:20000
    ds_read_b128 v[56:59], v6 offset:23936
    ds_read_b128 v[60:63], v6 offset:25248
    s_waitcnt lgkmcnt(0)
    v_readfirstlane_b32 s21, v11
    v_pk_mul_f32 v[32:33], v[32:33], v[26:27] op_sel_hi:[1,0]
    v_pk_mul_f32 v[34:35], v[34:35], v[26:27] op_sel_hi:[1,0]
    v_pk_mul_f32 v[36:37], v[36:37], v[26:27] op_sel_hi:[1,0]
    v_pk_mul_f32 v[38:39], v[38:39], v[26:27] op_sel_hi:[1,0]
    s_cmp_lt_u32 s21, 4
    s_cbranch_scc1 L_hpv
    v_pk_fma_f32 v[32:33], v[40:41], v[26:27], v[32:33] op_sel:[0,1,0] op_sel_hi:[1,1,1]
    v_pk_fma_f32 v[34:35], v[42:43], v[26:27], v[34:35] op_sel:[0,1,0] op_sel_hi:[1,1,1]
    v_pk_fma_f32 v[36:37], v[44:45], v[26:27], v[36:37] op_sel:[0,1,0] op_sel_hi:[1,1,1]
    v_pk_fma_f32 v[38:39], v[46:47], v[26:27], v[38:39] op_sel:[0,1,0] op_sel_hi:[1,1,1]
    v_pk_fma_f32 v[32:33], v[48:49], v[28:29], v[32:33] op_sel_hi:[1,0,1]
    v_pk_fma_f32 v[34:35], v[50:51], v[28:29], v[34:35] op_sel_hi:[1,0,1]
    v_pk_fma_f32 v[36:37], v[52:53], v[28:29], v[36:37] op_sel_hi:[1,0,1]
    v_pk_fma_f32 v[38:39], v[54:55], v[28:29], v[38:39] op_sel_hi:[1,0,1]
    v_pk_fma_f32 v[32:33], v[56:57], v[28:29], v[32:33] op_sel:[0,1,0] op_sel_hi:[1,1,1]
    v_pk_fma_f32 v[34:35], v[58:59], v[28:29], v[34:35] op_sel:[0,1,0] op_sel_hi:[1,1,1]
    v_pk_fma_f32 v[36:37], v[60:61], v[28:29], v[36:37] op_sel:[0,1,0] op_sel_hi:[1,1,1]
    v_pk_fma_f32 v[38:39], v[62:63], v[28:29], v[38:39] op_sel:[0,1,0] op_sel_hi:[1,1,1]
    v_perm_b32 v64, v36, v32, s53
    v_perm_b32 v65, v37, v33, s53
    v_perm_b32 v66, v38, v34, s53
    v_perm_b32 v67, v39, v35, s53
    v_pk_add_u16 v64, v64, v114
    v_pk_add_u16 v65, v65, v114
    v_pk_add_u16 v66, v66, v114
    v_pk_add_u16 v67, v67, v114
    v_bfi_b32 v64, v114, v108, v64
    v_bfi_b32 v65, v114, v109, v65
    v_bfi_b32 v66, v114, v110, v66
    v_bfi_b32 v67, v114, v111, v67
    buffer_store_dwordx4 v[64:67], v2, s[48:51], s19 offen sc1
    s_mov_b64 exec, s[56:57]
    buffer_store_dwordx2 v[14:15], v7, s[48:51], s5 offen sc1
    s_mov_b64 exec, -1
    s_branch L_fin
L_h23:
    s_cmp_lg_u32 s3, 2
    s_cbranch_scc1 L_hpvw
    buffer_load_dword v28, v30, s[48:51], s32 offen sc1
L_hpvw:
    ds_read_b32 v11, v9 offset:12
    ds_read_b32 v14, v9 offset:48
    s_waitcnt lgkmcnt(0)
    v_readfirstlane_b32 s21, v11
    s_cmp_lt_u32 s21, 4
    s_cbranch_scc1 L_hpvw
    v_readfirstlane_b32 s22, v14
    s_cmp_ge_i32 s22, 0
    s_cselect_b32 s22, 0, 0x2000
    s_mov_b32 s17, 1
    v_mov_b32 v32, 0
    s_lshl_b32 s21, s9, 4
L_flip:
    s_xor_b32 s20, s20, s22
    s_xor_b32 s28, s28, s22
    s_xor_b32 s29, s29, s22
L_cop1:
    s_load_dwordx16 s[64:79], s[48:49], s20 glc
    s_load_dwordx16 s[80:95], s[48:49], s20 offset:64 glc
    s_cmp_gt_u32 s17, 0x100000
    s_waitcnt lgkmcnt(0)
    s_cbranch_scc1 L_cod
    s_add_u32 s22, s65, s67
    s_add_u32 s22, s22, s69
    s_add_u32 s22, s22, s71
    s_add_u32 s22, s22, s73
    s_add_u32 s22, s22, s75
    s_add_u32 s22, s22, s77
    s_add_u32 s22, s22, s79
    s_add_u32 s22, s22, s81
    s_add_u32 s22, s22, s83
    s_add_u32 s22, s22, s85
    s_add_u32 s22, s22, s87
    s_add_u32 s22, s22, s89
    s_add_u32 s22, s22, s91
    s_add_u32 s22, s22, s93
    s_add_u32 s22, s22, s95
    s_cmp_lg_u32 s22, s21
    s_cbranch_scc1 L_cop
    buffer_load_dwordx4 v[40:43], v8, s[48:51], s28 offen offset:0 sc1
    buffer_load_dwordx4 v[44:47], v8, s[48:51], s28 offen offset:2048 sc1
    buffer_load_dwordx4 v[48:51], v8, s[48:51], s29 offen offset:0 sc1
    buffer_load_dwordx4 v[52:55], v8, s[48:51], s29 offen offset:2048 sc1
    s_or_b64 s[22:23], s[64:65], s[66:67]
    s_and_b64 s[26:27], s[64:65], s[66:67]
    s_or_b64 s[22:23], s[22:23], s[68:69]
    s_and_b64 s[26:27], s[26:27], s[68:69]
    s_or_b64 s[22:23], s[22:23], s[70:71]
    s_and_b64 s[26:27], s[26:27], s[70:71]
    s_or_b64 s[22:23], s[22:23], s[72:73]
    s_and_b64 s[26:27], s[26:27], s[72:73]
    s_or_b64 s[22:23], s[22:23], s[74:75]
    s_and_b64 s[26:27], s[26:27], s[74:75]
    s_or_b64 s[22:23], s[22:23], s[76:77]
    s_and_b64 s[26:27], s[26:27], s[76:77]
    s_or_b64 s[22:23], s[22:23], s[78:79]
    s_and_b64 s[26:27], s[26:27], s[78:79]
    s_or_b64 s[22:23], s[22:23], s[80:81]
    s_and_b64 s[26:27], s[26:27], s[80:81]
    s_or_b64 s[22:23], s[22:23], s[82:83]
    s_and_b64 s[26:27], s[26:27], s[82:83]
    s_or_b64 s[22:23], s[22:23], s[84:85]
    s_and_b64 s[26:27], s[26:27], s[84:85]
    s_or_b64 s[22:23], s[22:23], s[86:87]
    s_and_b64 s[26:27], s[26:27], s[86:87]
    s_or_b64 s[22:23], s[22:23], s[88:89]
    s_and_b64 s[26:27], s[26:27], s[88:89]
    s_or_b64 s[22:23], s[22:23], s[90:91]
    s_and_b64 s[26:27], s[26:27], s[90:91]
    s_or_b64 s[22:23], s[22:23], s[92:93]
    s_and_b64 s[26:27], s[26:27], s[92:93]
    s_or_b64 s[22:23], s[22:23], s[94:95]
    s_and_b64 s[26:27], s[26:27], s[94:95]
    s_xor_b64 s[22:23], s[22:23], s[8:9]
    s_xor_b64 s[26:27], s[26:27], s[8:9]
    s_or_b64 s[22:23], s[22:23], s[26:27]
    s_and_b32 s22, s22, 0xff
    s_or_b32 s22, s22, s23
    s_cbranch_scc1 L_cop
L_cod:
    s_mov_b64 exec, 1
    ds_add_u32 v9, v10 offset:24
    s_mov_b64 exec, -1
    v_writelane_b32 v32, s64, 0
    v_writelane_b32 v32, s66, 1
    v_writelane_b32 v32, s68, 2
    v_writelane_b32 v32, s70, 3
    v_writelane_b32 v32, s72, 4
    v_writelane_b32 v32, s74, 5
    v_writelane_b32 v32, s76, 6
    v_writelane_b32 v32, s78, 7
    v_writelane_b32 v32, s80, 8
    v_writelane_b32 v32, s82, 9
    v_writelane_b32 v32, s84, 10
    v_writelane_b32 v32, s86, 11
    v_writelane_b32 v32, s88, 12
    v_writelane_b32 v32, s90, 13
    v_writelane_b32 v32, s92, 14
    v_writelane_b32 v32, s94, 15
    v_and_b32 v32, 0xffffff00, v32
    s_nop 1
    v_max_f32_dpp v33, v32, v32 row_ror:8 row_mask:0xf bank_mask:0xf
    s_nop 1
    v_max_f32_dpp v33, v33, v33 row_ror:4 row_mask:0xf bank_mask:0xf
    s_nop 1
    v_max_f32_dpp v33, v33, v33 row_ror:2 row_mask:0xf bank_mask:0xf
    s_nop 1
    v_max_f32_dpp v33, v33, v33 row_ror:1 row_mask:0xf bank_mask:0xf
    v_sub_f32 v32, v32, v33
    v_exp_f32 v32, v32
    s_nop 1
    v_add_f32_dpp v33, v32, v32 row_ror:8 row_mask:0xf bank_mask:0xf
    s_nop 1
    v_add_f32_dpp v33, v33, v33 row_ror:4 row_mask:0xf bank_mask:0xf
    s_nop 1
    v_add_f32_dpp v33, v33, v33 row_ror:2 row_mask:0xf bank_mask:0xf
    s_nop 1
    v_add_f32_dpp v33, v33, v33 row_ror:1 row_mask:0xf bank_mask:0xf
    v_rcp_f32 v33, v33
    s_nop 0
    v_mul_f32 v32, v32, v33
    v_cvt_pk_bf16_f32 v32, v32, v32
    s_mov_b64 exec, 0xffff
    ds_write_b16 v20, v32 offset:384
    s_mov_b64 exec, -1
    ds_read_b64 v[34:35], v22 offset:384
    s_mov_b32 s17, 0
    s_mov_b32 s22, 0x11111111
    s_mov_b32 s23, s22
    s_mov_b32 s56, 0x000f000f
    s_mov_b32 s57, s56
    s_waitcnt lgkmcnt(0)
    v_cndmask_b32 v56, 0, v34, s[22:23]
    v_cndmask_b32 v57, 0, v35, s[22:23]
    s_lshl_b64 s[22:23], s[22:23], 1
    v_cndmask_b32 v58, 0, v34, s[22:23]
    v_cndmask_b32 v59, 0, v35, s[22:23]
    s_lshl_b64 s[22:23], s[22:23], 1
    v_cndmask_b32 v60, 0, v34, s[22:23]
    v_cndmask_b32 v61, 0, v35, s[22:23]
    s_lshl_b64 s[22:23], s[22:23], 1
    v_cndmask_b32 v62, 0, v34, s[22:23]
    v_cndmask_b32 v63, 0, v35, s[22:23]
L_ho1:
    s_waitcnt vmcnt(0)
    v_xor_b32 v40, v108, v40
    v_xor_b32 v44, v108, v44
    v_xor_b32 v48, v108, v48
    v_xor_b32 v52, v108, v52
    v_perm_b32 v72, v44, v40, s52
    v_perm_b32 v73, v52, v48, s52
    v_perm_b32 v74, v44, v40, s53
    v_perm_b32 v75, v52, v48, s53
    v_xor_b32 v41, v109, v41
    v_xor_b32 v45, v109, v45
    v_xor_b32 v49, v109, v49
    v_xor_b32 v53, v109, v53
    v_perm_b32 v76, v45, v41, s52
    v_perm_b32 v77, v53, v49, s52
    v_perm_b32 v78, v45, v41, s53
    v_perm_b32 v79, v53, v49, s53
    v_mfma_f32_16x16x16_bf16 v[88:91], v[72:73], v[56:57], 0
    v_mfma_f32_16x16x16_bf16 v[92:95], v[74:75], v[56:57], 0
    v_xor_b32 v42, v110, v42
    v_xor_b32 v46, v110, v46
    v_xor_b32 v50, v110, v50
    v_xor_b32 v54, v110, v54
    v_perm_b32 v80, v46, v42, s52
    v_perm_b32 v81, v54, v50, s52
    v_perm_b32 v82, v46, v42, s53
    v_perm_b32 v83, v54, v50, s53
    v_mfma_f32_16x16x16_bf16 v[88:91], v[76:77], v[58:59], v[88:91]
    v_mfma_f32_16x16x16_bf16 v[92:95], v[78:79], v[58:59], v[92:95]
    v_xor_b32 v43, v111, v43
    v_xor_b32 v47, v111, v47
    v_xor_b32 v51, v111, v51
    v_xor_b32 v55, v111, v55
    v_perm_b32 v84, v47, v43, s52
    v_perm_b32 v85, v55, v51, s52
    v_perm_b32 v86, v47, v43, s53
    v_perm_b32 v87, v55, v51, s53
    v_mfma_f32_16x16x16_bf16 v[88:91], v[80:81], v[60:61], v[88:91]
    v_mfma_f32_16x16x16_bf16 v[92:95], v[82:83], v[60:61], v[92:95]
    v_mfma_f32_16x16x16_bf16 v[88:91], v[84:85], v[62:63], v[88:91]
    v_mfma_f32_16x16x16_bf16 v[92:95], v[86:87], v[62:63], v[92:95]
    v_or3_b32 v11, v40, v41, v42
    v_or3_b32 v12, v43, v44, v45
    v_or3_b32 v11, v46, v47, v11
    v_or3_b32 v12, v48, v49, v12
    v_or3_b32 v11, v50, v51, v11
    v_or3_b32 v12, v52, v53, v12
    v_or3_b32 v11, v54, v55, v11
    v_or_b32 v11, v11, v12
    v_and_b32 v11, v114, v11
    v_cmp_ne_u32 vcc, 0, v11
    v_cvt_pk_bf16_f32 v32, v88, v92
    v_cvt_pk_bf16_f32 v33, v89, v93
    v_cvt_pk_bf16_f32 v34, v90, v94
    v_cvt_pk_bf16_f32 v35, v91, v95
    s_cbranch_vccnz L_oretry
L_ho2:
    s_mov_b64 exec, s[56:57]
    ds_write_b128 v23, v[32:35] offset:512
    s_mov_b64 exec, 1
    ds_add_u32 v9, v10 offset:16
    s_mov_b64 exec, -1
L_odone:
    s_cmp_lg_u32 s3, 2
    s_cbranch_scc1 L_fin
    s_mov_b32 s17, 0
    s_mov_b32 s56, 0x000f000f
    s_mov_b32 s57, 0x000f000f
    s_waitcnt vmcnt(0)
    s_mov_b64 vcc, -1
    s_branch L_hf3
L_hfw:
    ds_read_b32 v11, v9 offset:40
    s_waitcnt lgkmcnt(0)
    v_readfirstlane_b32 s21, v11
    s_cmp_lt_u32 s21, 1
    s_cbranch_scc1 L_hfw
    buffer_load_dwordx4 v[32:35], v2, s[48:51], s32 offen offset:0 sc1
    buffer_load_dwordx4 v[36:39], v2, s[48:51], s32 offen offset:1024 sc1
L_hf1:
    buffer_load_dwordx4 v[40:43], v2, s[48:51], s32 offen offset:0 sc1
    buffer_load_dwordx4 v[44:47], v2, s[48:51], s32 offen offset:1024 sc1
    s_waitcnt vmcnt(2)
    v_xor_b32 v32, s60, v32
    v_xor_b32 v33, s61, v33
    v_xor_b32 v34, s62, v34
    v_xor_b32 v35, s63, v35
    v_xor_b32 v36, s60, v36
    v_xor_b32 v37, s61, v37
    v_xor_b32 v38, s62, v38
    v_xor_b32 v39, s63, v39
    v_or3_b32 v11, v32, v33, v34
    v_or3_b32 v12, v35, v36, v37
    v_or3_b32 v11, v38, v39, v11
    v_or_b32 v11, v11, v12
    v_and_b32 v11, 0x7ff, v11
    v_cmp_ne_u32 vcc, 0, v11
    v_pk_add_f32 v[48:49], v[32:33], v[36:37]
    v_pk_add_f32 v[50:51], v[34:35], v[38:39]
    s_cbranch_vccz L_hf3
    buffer_load_dwordx4 v[32:35], v2, s[48:51], s32 offen offset:0 sc1
    buffer_load_dwordx4 v[36:39], v2, s[48:51], s32 offen offset:1024 sc1
    s_waitcnt vmcnt(2)
    v_xor_b32 v40, s60, v40
    v_xor_b32 v41, s61, v41
    v_xor_b32 v42, s62, v42
    v_xor_b32 v43, s63, v43
    v_xor_b32 v44, s60, v44
    v_xor_b32 v45, s61, v45
    v_xor_b32 v46, s62, v46
    v_xor_b32 v47, s63, v47
    v_or3_b32 v11, v40, v41, v42
    v_or3_b32 v12, v43, v44, v45
    v_or3_b32 v11, v46, v47, v11
    v_or_b32 v11, v11, v12
    v_and_b32 v11, 0x7ff, v11
    v_cmp_ne_u32 vcc, 0, v11
    v_pk_add_f32 v[48:49], v[40:41], v[44:45]
    v_pk_add_f32 v[50:51], v[42:43], v[46:47]
    s_cbranch_vccz L_hf3
    s_add_u32 s17, s17, 1
    s_cmp_le_u32 s17, 0x100000
    s_cbranch_scc1 L_hf1
    s_mov_b64 vcc, 0
L_hf3:
    s_nop 0
    v_permlane32_swap_b32 v48, v50
    v_permlane32_swap_b32 v49, v51
    s_nop 0
    v_pk_add_f32 v[48:49], v[48:49], v[50:51]
    s_nop 1
    v_permlane16_swap_b32 v48, v49
    s_nop 0
    v_add_f32 v48, v48, v49
    s_nop 1
    v_add_f32_dpp v48, v48, v48 row_ror:4 row_mask:0xf bank_mask:0xf
    s_nop 1
    v_add_f32_dpp v48, v48, v48 row_ror:8 row_mask:0xf bank_mask:0xf
    v_cvt_pk_bf16_f32 v48, v48, v48
    s_cbranch_vccnz L_hfw
    s_mov_b64 exec, s[56:57]
    global_store_short v25, v48, s[24:25]
    s_cmp_lg_u32 s2, s4
    s_cbranch_scc1 L_fin
    s_lshl_b32 s14, s4, 5
    s_add_u32 s14, s14, 0x40000
    v_mov_b32 v14, s8
    v_mov_b32 v15, s9
    s_mov_b64 exec, 1
    buffer_store_dwordx2 v[14:15], v9, s[48:51], s14 offen
L_fin:
L_end:
    s_endpgm
L_qslow:
    v_and_b32 v12, 0x7c0, v12
    v_or_b32 v11, v11, v12
    v_cmp_ne_u32 vcc, 0, v11
    s_add_u32 s17, s17, 1
    s_cbranch_vccz L_qfor
    s_cmp_gt_u32 s17, 0x100000
    s_cbranch_scc1 L_hq3
    s_cmp_lg_u32 s17, 8
    s_cbranch_scc1 L_hq1
    s_mov_b64 exec, 1
    ds_add_u32 v9, v10 offset:32
    s_mov_b64 exec, -1
    s_cmp_lg_u32 s3, 0
    s_cbranch_scc1 L_hq1
    buffer_store_dwordx4 v[104:107], v2, s[48:51], s23 offen sc1
    s_mov_b32 s33, 1
    s_branch L_hq1
L_qfor:
    s_mov_b64 exec, 1
    ds_add_u32 v9, v10 offset:28
    s_mov_b64 exec, -1
    s_mov_b64 exec, 1
    ds_add_u32 v9, v10 offset:32
    s_mov_b64 exec, -1
    s_branch L_hq3
L_repub:
    s_cmp_lg_u32 s33, 0
    s_cbranch_scc1 L_hst1
    buffer_store_dwordx4 v[104:107], v2, s[48:51], s23 offen sc1
    s_mov_b32 s33, 1
    s_branch L_hst1
L_cop:
    s_add_u32 s17, s17, 1
    s_and_b32 s22, s17, 14
    s_cbranch_scc1 L_cop1
    s_movk_i32 s22, 0x2000
    s_branch L_flip
L_oretry:
    s_add_u32 s17, s17, 1
    s_cmp_gt_u32 s17, 0x100000
    s_cbranch_scc1 L_ho2
    buffer_load_dwordx4 v[40:43], v8, s[48:51], s28 offen offset:0 sc1
    buffer_load_dwordx4 v[44:47], v8, s[48:51], s28 offen offset:2048 sc1
    buffer_load_dwordx4 v[48:51], v8, s[48:51], s29 offen offset:0 sc1
    buffer_load_dwordx4 v[52:55], v8, s[48:51], s29 offen offset:2048 sc1
    s_branch L_ho1
    .fill (10240 + 256 - (. - concat_heads__sliding_block_cached__sliding_block_cached__decode_kernel)) / 4, 4, 0xbf810000
.section .rodata,"a"
.p2align 6
.amdhsa_kernel concat_heads__sliding_block_cached__sliding_block_cached__decode_kernel
  .amdhsa_next_free_vgpr 256
  .amdhsa_next_free_sgpr 96
  .amdhsa_accum_offset 256
  .amdhsa_group_segment_fixed_size 0
  .amdhsa_kernarg_size 104
  .amdhsa_user_sgpr_count 2
  .amdhsa_user_sgpr_kernarg_segment_ptr 1
  .amdhsa_system_sgpr_workgroup_id_x 1
.end_amdhsa_kernel
```
